```python
import torch

def _softmax(x, axis=-1):
    return torch.softmax(x, dim=axis)
def _gelu(x):
    return torch.nn.functional.gelu(x, approximate="tanh")
def _silu(x):
    return torch.nn.functional.silu(x)
def _sigmoid(x):
    return torch.sigmoid(x)
def _layernorm(x, axis=-1, eps=1e-5):
    m = x.mean(dim=axis, keepdim=True)
    v = x.var(dim=axis, keepdim=True, unbiased=False)
    return (x - m) / torch.sqrt(v + eps)
def _scatter_add(tgt, idx, src, axis=0):
    return tgt.clone().index_add_(axis, idx, src)
def _segment_sum(src, seg, n):
    out = torch.zeros((n,) + src.shape[1:], dtype=src.dtype)
    return out.index_add_(0, seg, src)
def _pad(x, pw):
    flat = tuple(v for pair in reversed(pw) for v in pair)
    return torch.nn.functional.pad(x, flat)

kernel_name = 'gated_mix__compressed_kv_cla__swiglu_ffn__decode'

def setup_inputs():

    _w = (lambda a: (lambda t: t.to(torch.bfloat16) if t.is_floating_point() else t)(torch.as_tensor(a)))
    def _A_setup():
        B, H, Sq, Sk, D, M = 1, 32, 1, 8192, 128, 512
        Dc = 4 * D
        return {
            "x": _w((lambda *s: torch.randn(*s, dtype=torch.bfloat16) * 0.05)(B, Sq, M)),
            "c_kv": _w((lambda *s: torch.randn(*s, dtype=torch.bfloat16) * 0.8)(B, Sk, Dc)),
            "w_q": _w((lambda *s: torch.randn(*s, dtype=torch.bfloat16) * 6.4)(M, H, D) * (M ** -0.5)),
            "w_uk": _w((lambda *s: torch.randn(*s, dtype=torch.bfloat16) * 6.4)(Dc, H, D) * (Dc ** -0.5)),
            "w_uv": _w((lambda *s: torch.randn(*s, dtype=torch.bfloat16) * 0.8)(Dc, H, D) * (Dc ** -0.5)),
            "w_o": _w((lambda *s: torch.randn(*s, dtype=torch.bfloat16) * 0.8)(H, D, M) * ((H * D) ** -0.5)),
        }
    _A_in = _A_setup()

    def _B_setup():
        B, S, D, F = 1, 1, 512, 1376
        return {
            "x": _w((lambda *s: torch.randn(*s, dtype=torch.bfloat16) * 0.05)(B, S, D)),
            "w_gate": _w((lambda *s: torch.randn(*s, dtype=torch.bfloat16) * 0.1)(D, F)),
            "w_up": _w((lambda *s: torch.randn(*s, dtype=torch.bfloat16) * 0.1)(D, F)),
            "w_down": _w((lambda *s: torch.randn(*s, dtype=torch.bfloat16) * 0.1)(F, D)),
        }
    _B_in = _B_setup()

    return {
        "A_x": _A_in["x"],
        "A_c_kv": _A_in["c_kv"],
        "A_w_q": _A_in["w_q"],
        "A_w_uk": _A_in["w_uk"],
        "A_w_uv": _A_in["w_uv"],
        "A_w_o": _A_in["w_o"],
        "B_x": _B_in["x"],
        "B_w_gate": _B_in["w_gate"],
        "B_w_up": _B_in["w_up"],
        "B_w_down": _B_in["w_down"],
        "gate_w": _w((lambda *s: torch.randn(*s, dtype=torch.bfloat16) * 0.05)(512) * 16.0),
    }

def reference(A_x, A_c_kv, A_w_q, A_w_uk, A_w_uv, A_w_o, B_x, B_w_gate, B_w_up, B_w_down, gate_w):
    def _A_ref(x, c_kv, w_q, w_uk, w_uv, w_o):
        B, Sq, M = x.shape[0], x.shape[1], x.shape[2]
        Sk = c_kv.shape[1]
        H, D = w_q.shape[1], w_q.shape[2]
        q = torch.einsum("bqm,mhd->bhqd", x, w_q)
        k = torch.einsum("bkc,chd->bhkd", c_kv, w_uk)
        v = torch.einsum("bkc,chd->bhkd", c_kv, w_uv)
        scores = torch.einsum("bhqd,bhkd->bhqk", q, k) * (D ** -0.5)
        off = Sk - Sq
        qi = torch.arange(Sq)[:, None]
        kj = torch.arange(Sk)[None, :]
        cmask = kj <= (qi + off)
        scores = torch.where(cmask[None, None], scores, -1e9)
        p = _softmax(scores, axis=-1)
        ctx = torch.einsum("bhqk,bhkd->bhqd", p, v)
        return torch.einsum("bhqd,hdm->bqm", ctx, w_o)

    def _B_ref(x, w_gate, w_up, w_down):
        g = _silu(x @ w_gate)
        u = x @ w_up
        return (g * u) @ w_down

    x = A_x
    g = _sigmoid((x * gate_w).sum(-1, keepdims=True))
    a = _A_ref(x, A_c_kv, A_w_q, A_w_uk, A_w_uv, A_w_o)
    b = _B_ref(x, B_w_gate, B_w_up, B_w_down)
    return g * a + (1 - g) * b
```

```asm
; @launch kernel=k1_kernel grid=(428,1,1) block=(256,1,1) lds=17408
; @launch kernel=k2_kernel grid=(342,1,1) block=(256,1,1) lds=1024
; @launch kernel=k3_kernel grid=(256,1,1) block=(256,1,1) lds=69120
; @launch kernel=k4_kernel grid=(256,1,1) block=(256,1,1) lds=20480
; @launch kernel=k5_kernel grid=(256,1,1) block=(256,1,1) lds=9216
; @launch kernel=k6_kernel grid=(16,1,1) block=(256,1,1) lds=8448
.amdgcn_target "amdgcn-amd-amdhsa--gfx950"
.text
.globl k1_kernel
.p2align 8
.type k1_kernel,@function
k1_kernel:
    s_cmp_ge_u32 s2, 428
    s_cbranch_scc1 K1_END
    s_load_dwordx2 s[4:5], s[0:1], 0
    s_load_dwordx2 s[6:7], s[0:1], 16
    s_load_dwordx2 s[10:11], s[0:1], 104
    s_load_dwordx4 s[12:15], s[0:1], 56
    s_waitcnt lgkmcnt(0)
    s_mov_b32 s20, s4
    s_and_b32 s21, s5, 0xffff
    s_mov_b32 s22, 0x400
    s_mov_b32 s23, 0x00020000
    s_mov_b32 s32, s10
    s_and_b32 s33, s11, 0xffff
    s_mov_b32 s34, 0x800000
    s_mov_b32 s35, 0x00020000
    s_cmp_ge_u32 s2, 256
    s_cbranch_scc1 K1_FFN
    s_mov_b32 s24, s6
    s_and_b32 s25, s7, 0xffff
    s_mov_b32 s26, 0x400000
    s_mov_b32 s27, 0x00020000
    s_lshr_b32 s41, s2, 3
    s_and_b32 s42, s2, 7
    v_and_b32 v1, 15, v0
    v_lshrrev_b32 v2, 4, v0
    s_lshl_b32 s43, s42, 19
    s_lshl_b32 s44, s41, 8
    s_add_u32 s43, s43, s44
    v_lshlrev_b32 v3, 15, v2
    v_lshl_add_u32 v3, v1, 4, v3
    v_add_u32 v3, s43, v3
    s_lshl_b32 s44, s42, 7
    v_lshlrev_b32 v4, 3, v2
    v_add_u32 v4, s44, v4
    buffer_load_dwordx2 v[10:11], v4, s[20:23], 0 offen
    s_movk_i32 s50, 8192
    s_movk_i32 s51, 16384
    s_movk_i32 s52, 24576
    buffer_load_dwordx4 v[32:35], v3, s[24:27], 0 offen
    buffer_load_dwordx4 v[36:39], v3, s[24:27], s50 offen
    buffer_load_dwordx4 v[40:43], v3, s[24:27], s51 offen
    buffer_load_dwordx4 v[44:47], v3, s[24:27], s52 offen
    v_mov_b32 v60, 0
    v_mov_b32 v61, 0
    v_mov_b32 v62, 0
    v_mov_b32 v63, 0
    v_mov_b32 v64, 0
    v_mov_b32 v65, 0
    v_mov_b32 v66, 0
    v_mov_b32 v67, 0
    s_waitcnt vmcnt(3)
    v_and_b32 v27, 0xffff, v10
    v_lshlrev_b32 v28, 16, v10
    v_dot2c_f32_bf16 v60, v32, v27
    v_dot2c_f32_bf16 v61, v32, v28
    v_dot2c_f32_bf16 v62, v33, v27
    v_dot2c_f32_bf16 v63, v33, v28
    v_dot2c_f32_bf16 v64, v34, v27
    v_dot2c_f32_bf16 v65, v34, v28
    v_dot2c_f32_bf16 v66, v35, v27
    v_dot2c_f32_bf16 v67, v35, v28
    s_waitcnt vmcnt(2)
    v_lshrrev_b32 v27, 16, v10
    v_and_b32 v28, 0xffff0000, v10
    v_dot2c_f32_bf16 v60, v36, v27
    v_dot2c_f32_bf16 v61, v36, v28
    v_dot2c_f32_bf16 v62, v37, v27
    v_dot2c_f32_bf16 v63, v37, v28
    v_dot2c_f32_bf16 v64, v38, v27
    v_dot2c_f32_bf16 v65, v38, v28
    v_dot2c_f32_bf16 v66, v39, v27
    v_dot2c_f32_bf16 v67, v39, v28
    s_waitcnt vmcnt(1)
    v_and_b32 v27, 0xffff, v11
    v_lshlrev_b32 v28, 16, v11
    v_dot2c_f32_bf16 v60, v40, v27
    v_dot2c_f32_bf16 v61, v40, v28
    v_dot2c_f32_bf16 v62, v41, v27
    v_dot2c_f32_bf16 v63, v41, v28
    v_dot2c_f32_bf16 v64, v42, v27
    v_dot2c_f32_bf16 v65, v42, v28
    v_dot2c_f32_bf16 v66, v43, v27
    v_dot2c_f32_bf16 v67, v43, v28
    s_waitcnt vmcnt(0)
    v_lshrrev_b32 v27, 16, v11
    v_and_b32 v28, 0xffff0000, v11
    v_dot2c_f32_bf16 v60, v44, v27
    v_dot2c_f32_bf16 v61, v44, v28
    v_dot2c_f32_bf16 v62, v45, v27
    v_dot2c_f32_bf16 v63, v45, v28
    v_dot2c_f32_bf16 v64, v46, v27
    v_dot2c_f32_bf16 v65, v46, v28
    v_dot2c_f32_bf16 v66, v47, v27
    v_dot2c_f32_bf16 v67, v47, v28
    v_lshlrev_b32 v29, 9, v2
    v_lshl_add_u32 v29, v1, 5, v29
    ds_write_b128 v29, v[60:63]
    ds_write_b128 v29, v[64:67] offset:16
    s_waitcnt lgkmcnt(0)
    s_barrier
    v_cmp_gt_u32 vcc, 128, v0
    s_and_saveexec_b64 s[48:49], vcc
    s_cbranch_execz K1_END
    v_lshlrev_b32 v29, 2, v0
    ds_read_b32 v32, v29 offset:0
    ds_read_b32 v33, v29 offset:512
    ds_read_b32 v34, v29 offset:1024
    ds_read_b32 v35, v29 offset:1536
    ds_read_b32 v36, v29 offset:2048
    ds_read_b32 v37, v29 offset:2560
    ds_read_b32 v38, v29 offset:3072
    ds_read_b32 v39, v29 offset:3584
    ds_read_b32 v40, v29 offset:4096
    ds_read_b32 v41, v29 offset:4608
    ds_read_b32 v42, v29 offset:5120
    ds_read_b32 v43, v29 offset:5632
    ds_read_b32 v44, v29 offset:6144
    ds_read_b32 v45, v29 offset:6656
    ds_read_b32 v46, v29 offset:7168
    ds_read_b32 v47, v29 offset:7680
    s_waitcnt lgkmcnt(0)
    v_add_f32 v32, v32, v33
    v_add_f32 v32, v32, v34
    v_add_f32 v32, v32, v35
    v_add_f32 v32, v32, v36
    v_add_f32 v32, v32, v37
    v_add_f32 v32, v32, v38
    v_add_f32 v32, v32, v39
    v_add_f32 v32, v32, v40
    v_add_f32 v32, v32, v41
    v_add_f32 v32, v32, v42
    v_add_f32 v32, v32, v43
    v_add_f32 v32, v32, v44
    v_add_f32 v32, v32, v45
    v_add_f32 v32, v32, v46
    v_add_f32 v32, v32, v47
    s_lshl_b32 s43, s42, 14
    s_lshl_b32 s44, s41, 9
    s_add_u32 s43, s43, s44
    v_add_u32 v29, s43, v29
    buffer_store_dword v32, v29, s[32:35], 0 offen
    s_waitcnt vmcnt(0)
    s_endpgm
K1_FFN:
    s_mov_b32 s24, s12
    s_and_b32 s25, s13, 0xffff
    s_mov_b32 s26, 0x158000
    s_mov_b32 s27, 0x00020000
    s_mov_b32 s28, s14
    s_and_b32 s29, s15, 0xffff
    s_mov_b32 s30, 0x158000
    s_mov_b32 s31, 0x00020000
    s_sub_u32 s41, s2, 256
    s_mov_b32 s42, 0
    s_cmp_ge_u32 s41, 86
    s_cselect_b32 s42, 2, 0
    s_mul_i32 s43, s42, 43
    s_sub_u32 s41, s41, s43
    s_cmp_ge_u32 s41, 43
    s_cselect_b32 s43, 1, 0
    s_add_u32 s42, s42, s43
    s_mul_i32 s43, s43, 43
    s_sub_u32 s41, s41, s43
    v_and_b32 v1, 3, v0
    v_lshrrev_b32 v2, 2, v0
    s_mul_i32 s43, s42, 352256
    s_lshl_b32 s44, s41, 6
    s_add_u32 s43, s43, s44
    s_movk_i32 s45, 5504
    v_mul_lo_u32 v3, v2, s45
    v_lshl_add_u32 v3, v1, 4, v3
    v_add_u32 v3, s43, v3
    s_lshl_b32 s44, s42, 8
    v_lshlrev_b32 v4, 2, v2
    v_add_u32 v4, s44, v4
    buffer_load_dword v10, v4, s[20:23], 0 offen
    buffer_load_dwordx4 v[32:35], v3, s[24:27], 0 offen
    buffer_load_dwordx4 v[36:39], v3, s[24:27], 0 offen offset:2752
    buffer_load_dwordx4 v[40:43], v3, s[28:31], 0 offen
    buffer_load_dwordx4 v[44:47], v3, s[28:31], 0 offen offset:2752
    v_mov_b32 v60, 0
    v_mov_b32 v61, 0
    v_mov_b32 v62, 0
    v_mov_b32 v63, 0
    v_mov_b32 v64, 0
    v_mov_b32 v65, 0
    v_mov_b32 v66, 0
    v_mov_b32 v67, 0
    v_mov_b32 v68, 0
    v_mov_b32 v69, 0
    v_mov_b32 v70, 0
    v_mov_b32 v71, 0
    v_mov_b32 v72, 0
    v_mov_b32 v73, 0
    v_mov_b32 v74, 0
    v_mov_b32 v75, 0
    s_waitcnt vmcnt(0)
    v_and_b32 v27, 0xffff, v10
    v_lshlrev_b32 v28, 16, v10
    v_dot2c_f32_bf16 v60, v32, v27
    v_dot2c_f32_bf16 v61, v32, v28
    v_dot2c_f32_bf16 v68, v40, v27
    v_dot2c_f32_bf16 v69, v40, v28
    v_dot2c_f32_bf16 v62, v33, v27
    v_dot2c_f32_bf16 v63, v33, v28
    v_dot2c_f32_bf16 v70, v41, v27
    v_dot2c_f32_bf16 v71, v41, v28
    v_dot2c_f32_bf16 v64, v34, v27
    v_dot2c_f32_bf16 v65, v34, v28
    v_dot2c_f32_bf16 v72, v42, v27
    v_dot2c_f32_bf16 v73, v42, v28
    v_dot2c_f32_bf16 v66, v35, v27
    v_dot2c_f32_bf16 v67, v35, v28
    v_dot2c_f32_bf16 v74, v43, v27
    v_dot2c_f32_bf16 v75, v43, v28
    v_lshrrev_b32 v27, 16, v10
    v_and_b32 v28, 0xffff0000, v10
    v_dot2c_f32_bf16 v60, v36, v27
    v_dot2c_f32_bf16 v61, v36, v28
    v_dot2c_f32_bf16 v68, v44, v27
    v_dot2c_f32_bf16 v69, v44, v28
    v_dot2c_f32_bf16 v62, v37, v27
    v_dot2c_f32_bf16 v63, v37, v28
    v_dot2c_f32_bf16 v70, v45, v27
    v_dot2c_f32_bf16 v71, v45, v28
    v_dot2c_f32_bf16 v64, v38, v27
    v_dot2c_f32_bf16 v65, v38, v28
    v_dot2c_f32_bf16 v72, v46, v27
    v_dot2c_f32_bf16 v73, v46, v28
    v_dot2c_f32_bf16 v66, v39, v27
    v_dot2c_f32_bf16 v67, v39, v28
    v_dot2c_f32_bf16 v74, v47, v27
    v_dot2c_f32_bf16 v75, v47, v28
    v_lshlrev_b32 v29, 7, v2
    v_lshl_add_u32 v29, v1, 5, v29
    ds_write_b128 v29, v[60:63]
    ds_write_b128 v29, v[64:67] offset:16
    ds_write_b128 v29, v[68:71] offset:8192
    ds_write_b128 v29, v[72:75] offset:8208
    s_waitcnt lgkmcnt(0)
    s_barrier
    v_and_b32 v29, 31, v0
    v_lshlrev_b32 v29, 2, v29
    v_bfe_u32 v30, v0, 5, 1
    v_lshl_add_u32 v29, v30, 13, v29
    v_lshrrev_b32 v30, 6, v0
    v_lshl_add_u32 v29, v30, 11, v29
    ds_read_b32 v32, v29 offset:0
    ds_read_b32 v33, v29 offset:128
    ds_read_b32 v34, v29 offset:256
    ds_read_b32 v35, v29 offset:384
    ds_read_b32 v36, v29 offset:512
    ds_read_b32 v37, v29 offset:640
    ds_read_b32 v38, v29 offset:768
    ds_read_b32 v39, v29 offset:896
    ds_read_b32 v40, v29 offset:1024
    ds_read_b32 v41, v29 offset:1152
    ds_read_b32 v42, v29 offset:1280
    ds_read_b32 v43, v29 offset:1408
    ds_read_b32 v44, v29 offset:1536
    ds_read_b32 v45, v29 offset:1664
    ds_read_b32 v46, v29 offset:1792
    ds_read_b32 v47, v29 offset:1920
    s_waitcnt lgkmcnt(0)
    v_add_f32 v32, v32, v33
    v_add_f32 v32, v32, v34
    v_add_f32 v32, v32, v35
    v_add_f32 v32, v32, v36
    v_add_f32 v32, v32, v37
    v_add_f32 v32, v32, v38
    v_add_f32 v32, v32, v39
    v_add_f32 v32, v32, v40
    v_add_f32 v32, v32, v41
    v_add_f32 v32, v32, v42
    v_add_f32 v32, v32, v43
    v_add_f32 v32, v32, v44
    v_add_f32 v32, v32, v45
    v_add_f32 v32, v32, v46
    v_add_f32 v32, v32, v47
    v_lshlrev_b32 v29, 2, v0
    ds_write_b32 v29, v32 offset:16384
    s_waitcnt lgkmcnt(0)
    s_barrier
    v_cmp_gt_u32 vcc, 64, v0
    s_and_saveexec_b64 s[48:49], vcc
    s_cbranch_execz K1_END
    ds_read_b32 v32, v29 offset:16384
    ds_read_b32 v33, v29 offset:16640
    ds_read_b32 v34, v29 offset:16896
    ds_read_b32 v35, v29 offset:17152
    s_waitcnt lgkmcnt(0)
    v_add_f32 v32, v32, v33
    v_add_f32 v34, v34, v35
    v_add_f32 v32, v32, v34
    v_and_b32 v30, 31, v0
    v_lshlrev_b32 v30, 2, v30
    v_bfe_u32 v31, v0, 5, 1
    v_lshl_add_u32 v30, v31, 15, v30
    s_lshl_b32 s43, s42, 13
    s_lshl_b32 s44, s41, 7
    s_add_u32 s43, s43, s44
    s_add_u32 s43, s43, 0x60000
    v_add_u32 v30, s43, v30
    buffer_store_dword v32, v30, s[32:35], 0 offen
    s_waitcnt vmcnt(0)
K1_END:
    s_endpgm

.globl k2_kernel
.p2align 8
.type k2_kernel,@function
k2_kernel:
    s_cmp_ge_u32 s2, 342
    s_cbranch_scc1 K2_END
    s_load_dwordx2 s[8:9], s[0:1], 24
    s_load_dwordx2 s[10:11], s[0:1], 104
    s_load_dwordx2 s[16:17], s[0:1], 72
    s_waitcnt lgkmcnt(0)
    s_mov_b32 s32, s10
    s_and_b32 s33, s11, 0xffff
    s_mov_b32 s34, 0x800000
    s_mov_b32 s35, 0x00020000
    s_cmp_ge_u32 s2, 256
    s_cbranch_scc1 K2_FFN
    s_mov_b32 s28, s8
    s_and_b32 s29, s9, 0xffff
    s_mov_b32 s30, 0x400000
    s_mov_b32 s31, 0x00020000
    s_lshr_b32 s41, s2, 3
    s_and_b32 s42, s2, 7
    v_and_b32 v5, 63, v0
    v_lshrrev_b32 v6, 6, v0
    v_and_b32 v7, 15, v5
    v_lshrrev_b32 v8, 4, v5
    s_lshl_b32 s43, s41, 8
    s_lshl_b32 s44, s42, 6
    v_lshl_add_u32 v9, v6, 4, v7
    v_add_u32 v9, s44, v9
    v_lshlrev_b32 v26, 13, v9
    v_lshl_add_u32 v26, v8, 6, v26
    v_add_u32 v26, s43, v26
    buffer_load_dwordx4 v[68:71], v26, s[28:31], 0 offen offset:0
    buffer_load_dwordx4 v[72:75], v26, s[28:31], 0 offen offset:16
    buffer_load_dwordx4 v[76:79], v26, s[28:31], 0 offen offset:32
    buffer_load_dwordx4 v[80:83], v26, s[28:31], 0 offen offset:48
    v_and_b32 v29, 127, v0
    v_lshlrev_b32 v29, 2, v29
    s_lshl_b32 s44, s41, 9
    v_add_u32 v30, s44, v29
    s_mov_b32 s50, 0
    s_mov_b32 s51, 16384
    s_mov_b32 s52, 32768
    s_mov_b32 s53, 49152
    s_mov_b32 s54, 65536
    s_mov_b32 s55, 81920
    s_mov_b32 s56, 98304
    s_mov_b32 s57, 114688
    buffer_load_dword v32, v30, s[32:35], s50 offen
    buffer_load_dword v33, v30, s[32:35], s51 offen
    buffer_load_dword v34, v30, s[32:35], s52 offen
    buffer_load_dword v35, v30, s[32:35], s53 offen
    buffer_load_dword v36, v30, s[32:35], s54 offen
    buffer_load_dword v37, v30, s[32:35], s55 offen
    buffer_load_dword v38, v30, s[32:35], s56 offen
    buffer_load_dword v39, v30, s[32:35], s57 offen
    s_waitcnt vmcnt(0)
    v_add_f32 v32, v32, v33
    v_add_f32 v32, v32, v34
    v_add_f32 v32, v32, v35
    v_add_f32 v32, v32, v36
    v_add_f32 v32, v32, v37
    v_add_f32 v32, v32, v38
    v_add_f32 v32, v32, v39
    v_cvt_pk_bf16_f32 v32, v32, v32
    v_lshrrev_b32 v29, 1, v29
    ds_write_b16 v29, v32
    s_waitcnt lgkmcnt(0)
    s_barrier
    v_lshlrev_b32 v29, 6, v8
    ds_read_b128 v[32:35], v29 offset:0
    ds_read_b128 v[36:39], v29 offset:16
    ds_read_b128 v[40:43], v29 offset:32
    ds_read_b128 v[44:47], v29 offset:48
    v_mov_b32 v84, 0
    v_mov_b32 v85, 0
    v_mov_b32 v86, 0
    v_mov_b32 v87, 0
    s_nop 1
    s_waitcnt lgkmcnt(0)
    v_mfma_f32_16x16x32_bf16 v[84:87], v[68:71], v[32:35], v[84:87]
    v_mfma_f32_16x16x32_bf16 v[84:87], v[72:75], v[36:39], v[84:87]
    v_mfma_f32_16x16x32_bf16 v[84:87], v[76:79], v[40:43], v[84:87]
    v_mfma_f32_16x16x32_bf16 v[84:87], v[80:83], v[44:47], v[84:87]
    s_nop 7
    s_nop 1
    s_mov_b32 s45, 0x3e0293ee
    v_mul_f32 v84, s45, v84
    v_mul_f32 v85, s45, v85
    v_mul_f32 v86, s45, v86
    v_mul_f32 v87, s45, v87
    v_cvt_pk_bf16_f32 v88, v84, v85
    v_cvt_pk_bf16_f32 v89, v86, v87
    s_lshl_b32 s46, s41, 10
    s_lshl_b32 s47, s42, 7
    s_add_u32 s46, s46, s47
    s_add_u32 s46, s46, 0x20000
    v_lshlrev_b32 v29, 5, v6
    v_lshl_add_u32 v29, v8, 3, v29
    v_add_u32 v29, s46, v29
    v_cmp_eq_u32 vcc, 0, v7
    s_and_saveexec_b64 s[48:49], vcc
    buffer_store_dwordx2 v[88:89], v29, s[32:35], 0 offen
    s_waitcnt vmcnt(0)
    s_endpgm
K2_FFN:
    s_mov_b32 s36, s16
    s_and_b32 s37, s17, 0xffff
    s_mov_b32 s38, 0x158000
    s_mov_b32 s39, 0x00020000
    s_sub_u32 s41, s2, 256
    s_lshl_b32 s44, s41, 14
    v_lshlrev_b32 v5, 2, v0
    v_add_u32 v5, s44, v5
    buffer_load_dword v64, v5, s[36:39], 0 offen offset:0
    buffer_load_dword v65, v5, s[36:39], 0 offen offset:1024
    buffer_load_dword v66, v5, s[36:39], 0 offen offset:2048
    buffer_load_dword v67, v5, s[36:39], 0 offen offset:3072
    v_add_u32 v5, 4096, v5
    buffer_load_dword v68, v5, s[36:39], 0 offen offset:0
    buffer_load_dword v69, v5, s[36:39], 0 offen offset:1024
    buffer_load_dword v70, v5, s[36:39], 0 offen offset:2048
    buffer_load_dword v71, v5, s[36:39], 0 offen offset:3072
    v_add_u32 v5, 4096, v5
    buffer_load_dword v72, v5, s[36:39], 0 offen offset:0
    buffer_load_dword v73, v5, s[36:39], 0 offen offset:1024
    buffer_load_dword v74, v5, s[36:39], 0 offen offset:2048
    buffer_load_dword v75, v5, s[36:39], 0 offen offset:3072
    v_add_u32 v5, 4096, v5
    buffer_load_dword v76, v5, s[36:39], 0 offen offset:0
    buffer_load_dword v77, v5, s[36:39], 0 offen offset:1024
    buffer_load_dword v78, v5, s[36:39], 0 offen offset:2048
    buffer_load_dword v79, v5, s[36:39], 0 offen offset:3072
    v_and_b32 v29, 15, v0
    v_lshlrev_b32 v29, 2, v29
    s_lshl_b32 s44, s41, 6
    s_add_u32 s44, s44, 0x60000
    v_add_u32 v30, s44, v29
    s_movk_i32 s50, 8192
    s_movk_i32 s51, 16384
    s_movk_i32 s52, 24576
    buffer_load_dword v32, v30, s[32:35], 0 offen
    buffer_load_dword v33, v30, s[32:35], s50 offen
    buffer_load_dword v34, v30, s[32:35], s51 offen
    buffer_load_dword v35, v30, s[32:35], s52 offen
    v_add_u32 v30, 0x8000, v30
    buffer_load_dword v36, v30, s[32:35], 0 offen
    buffer_load_dword v37, v30, s[32:35], s50 offen
    buffer_load_dword v38, v30, s[32:35], s51 offen
    buffer_load_dword v39, v30, s[32:35], s52 offen
    s_waitcnt vmcnt(0)
    v_add_f32 v32, v32, v33
    v_add_f32 v34, v34, v35
    v_add_f32 v32, v32, v34
    v_add_f32 v36, v36, v37
    v_add_f32 v38, v38, v39
    v_add_f32 v36, v36, v38
    v_cvt_pk_bf16_f32 v32, v32, v36
    v_lshlrev_b32 v33, 16, v32
    v_and_b32 v34, 0xffff0000, v32
    v_mul_f32 v35, 0xbfb8aa3b, v33
    v_exp_f32 v35, v35
    s_nop 0
    v_add_f32 v35, 1.0, v35
    v_rcp_f32 v35, v35
    s_nop 0
    v_mul_f32 v35, v33, v35
    v_cvt_pk_bf16_f32 v35, v35, v35
    v_lshlrev_b32 v35, 16, v35
    v_mul_f32 v35, v35, v34
    v_cvt_pk_bf16_f32 v35, v35, v35
    v_and_b32 v35, 0xffff, v35
    ds_write_b32 v29, v35
    s_waitcnt lgkmcnt(0)
    s_barrier
    v_mov_b32 v29, 0
    ds_read_b128 v[40:43], v29 offset:0
    ds_read_b128 v[44:47], v29 offset:16
    ds_read_b128 v[48:51], v29 offset:32
    ds_read_b128 v[52:55], v29 offset:48
    v_mov_b32 v60, 0
    v_mov_b32 v61, 0
    s_waitcnt lgkmcnt(0)
    v_lshlrev_b32 v30, 16, v40
    v_dot2c_f32_bf16 v60, v64, v40
    v_dot2c_f32_bf16 v61, v64, v30
    v_lshlrev_b32 v30, 16, v41
    v_dot2c_f32_bf16 v60, v65, v41
    v_dot2c_f32_bf16 v61, v65, v30
    v_lshlrev_b32 v30, 16, v42
    v_dot2c_f32_bf16 v60, v66, v42
    v_dot2c_f32_bf16 v61, v66, v30
    v_lshlrev_b32 v30, 16, v43
    v_dot2c_f32_bf16 v60, v67, v43
    v_dot2c_f32_bf16 v61, v67, v30
    v_lshlrev_b32 v30, 16, v44
    v_dot2c_f32_bf16 v60, v68, v44
    v_dot2c_f32_bf16 v61, v68, v30
    v_lshlrev_b32 v30, 16, v45
    v_dot2c_f32_bf16 v60, v69, v45
    v_dot2c_f32_bf16 v61, v69, v30
    v_lshlrev_b32 v30, 16, v46
    v_dot2c_f32_bf16 v60, v70, v46
    v_dot2c_f32_bf16 v61, v70, v30
    v_lshlrev_b32 v30, 16, v47
    v_dot2c_f32_bf16 v60, v71, v47
    v_dot2c_f32_bf16 v61, v71, v30
    v_lshlrev_b32 v30, 16, v48
    v_dot2c_f32_bf16 v60, v72, v48
    v_dot2c_f32_bf16 v61, v72, v30
    v_lshlrev_b32 v30, 16, v49
    v_dot2c_f32_bf16 v60, v73, v49
    v_dot2c_f32_bf16 v61, v73, v30
    v_lshlrev_b32 v30, 16, v50
    v_dot2c_f32_bf16 v60, v74, v50
    v_dot2c_f32_bf16 v61, v74, v30
    v_lshlrev_b32 v30, 16, v51
    v_dot2c_f32_bf16 v60, v75, v51
    v_dot2c_f32_bf16 v61, v75, v30
    v_lshlrev_b32 v30, 16, v52
    v_dot2c_f32_bf16 v60, v76, v52
    v_dot2c_f32_bf16 v61, v76, v30
    v_lshlrev_b32 v30, 16, v53
    v_dot2c_f32_bf16 v60, v77, v53
    v_dot2c_f32_bf16 v61, v77, v30
    v_lshlrev_b32 v30, 16, v54
    v_dot2c_f32_bf16 v60, v78, v54
    v_dot2c_f32_bf16 v61, v78, v30
    v_lshlrev_b32 v30, 16, v55
    v_dot2c_f32_bf16 v60, v79, v55
    v_dot2c_f32_bf16 v61, v79, v30
    s_lshl_b32 s44, s41, 11
    s_add_u32 s44, s44, 0x70000
    v_lshlrev_b32 v29, 3, v0
    v_add_u32 v29, s44, v29
    buffer_store_dwordx2 v[60:61], v29, s[32:35], 0 offen
    s_waitcnt vmcnt(0)
K2_END:
    s_endpgm

.globl k3_kernel
.p2align 8
.type k3_kernel,@function
k3_kernel:
    s_cmp_ge_u32 s2, 256
    s_cbranch_scc1 K3_END
    s_load_dwordx2 s[4:5], s[0:1], 8
    s_load_dwordx2 s[10:11], s[0:1], 104
    s_waitcnt lgkmcnt(0)
    s_mov_b32 s20, s4
    s_and_b32 s21, s5, 0xffff
    s_mov_b32 s22, 0x800000
    s_mov_b32 s23, 0x00020000
    s_mov_b32 s32, s10
    s_and_b32 s33, s11, 0xffff
    s_mov_b32 s34, 0x800000
    s_mov_b32 s35, 0x00020000
    s_and_b32 s40, s2, 7
    s_lshr_b32 s41, s2, 3
    s_and_b32 s42, s41, 1
    s_lshr_b32 s41, s41, 1
    s_lshl_b32 s41, s41, 3
    s_add_u32 s41, s41, s40
    v_and_b32 v1, 63, v0
    v_lshrrev_b32 v2, 6, v0
    v_and_b32 v3, 15, v1
    v_lshrrev_b32 v4, 4, v1
    s_nop 0
    v_readfirstlane_b32 s43, v2
    s_nop 3
    s_lshl_b32 s44, s41, 16
    s_lshl_b32 s45, s43, 14
    s_add_u32 s44, s44, s45
    v_lshlrev_b32 v5, 4, v1
    v_add_u32 v5, s44, v5
    s_mul_i32 s45, s43, 16640
    s_mov_b32 m0, s45
    s_nop 0
    buffer_load_dwordx4 v5, s[20:23], 0 offen lds
    v_add_u32 v5, 1024, v5
    s_add_u32 m0, m0, 1040
    s_nop 0
    buffer_load_dwordx4 v5, s[20:23], 0 offen lds
    v_add_u32 v5, 1024, v5
    s_add_u32 m0, m0, 1040
    s_nop 0
    buffer_load_dwordx4 v5, s[20:23], 0 offen lds
    v_add_u32 v5, 1024, v5
    s_add_u32 m0, m0, 1040
    s_nop 0
    buffer_load_dwordx4 v5, s[20:23], 0 offen lds
    v_add_u32 v5, 1024, v5
    s_add_u32 m0, m0, 1040
    s_nop 0
    buffer_load_dwordx4 v5, s[20:23], 0 offen lds
    v_add_u32 v5, 1024, v5
    s_add_u32 m0, m0, 1040
    s_nop 0
    buffer_load_dwordx4 v5, s[20:23], 0 offen lds
    v_add_u32 v5, 1024, v5
    s_add_u32 m0, m0, 1040
    s_nop 0
    buffer_load_dwordx4 v5, s[20:23], 0 offen lds
    v_add_u32 v5, 1024, v5
    s_add_u32 m0, m0, 1040
    s_nop 0
    buffer_load_dwordx4 v5, s[20:23], 0 offen lds
    v_add_u32 v5, 1024, v5
    s_add_u32 m0, m0, 1040
    s_nop 0
    buffer_load_dwordx4 v5, s[20:23], 0 offen lds
    v_add_u32 v5, 1024, v5
    s_add_u32 m0, m0, 1040
    s_nop 0
    buffer_load_dwordx4 v5, s[20:23], 0 offen lds
    v_add_u32 v5, 1024, v5
    s_add_u32 m0, m0, 1040
    s_nop 0
    buffer_load_dwordx4 v5, s[20:23], 0 offen lds
    v_add_u32 v5, 1024, v5
    s_add_u32 m0, m0, 1040
    s_nop 0
    buffer_load_dwordx4 v5, s[20:23], 0 offen lds
    v_add_u32 v5, 1024, v5
    s_add_u32 m0, m0, 1040
    s_nop 0
    buffer_load_dwordx4 v5, s[20:23], 0 offen lds
    v_add_u32 v5, 1024, v5
    s_add_u32 m0, m0, 1040
    s_nop 0
    buffer_load_dwordx4 v5, s[20:23], 0 offen lds
    v_add_u32 v5, 1024, v5
    s_add_u32 m0, m0, 1040
    s_nop 0
    buffer_load_dwordx4 v5, s[20:23], 0 offen lds
    v_add_u32 v5, 1024, v5
    s_add_u32 m0, m0, 1040
    s_nop 0
    buffer_load_dwordx4 v5, s[20:23], 0 offen lds
    s_lshl_b32 s45, s42, 14
    s_add_u32 s45, s45, 0x20000
    v_lshlrev_b32 v6, 10, v3
    v_lshl_add_u32 v6, v4, 4, v6
    v_add_u32 v6, s45, v6
    buffer_load_dwordx4 v[16:19], v6, s[32:35], 0 offen offset:0
    buffer_load_dwordx4 v[20:23], v6, s[32:35], 0 offen offset:64
    buffer_load_dwordx4 v[24:27], v6, s[32:35], 0 offen offset:128
    buffer_load_dwordx4 v[28:31], v6, s[32:35], 0 offen offset:192
    buffer_load_dwordx4 v[32:35], v6, s[32:35], 0 offen offset:256
    buffer_load_dwordx4 v[36:39], v6, s[32:35], 0 offen offset:320
    buffer_load_dwordx4 v[40:43], v6, s[32:35], 0 offen offset:384
    buffer_load_dwordx4 v[44:47], v6, s[32:35], 0 offen offset:448
    buffer_load_dwordx4 v[48:51], v6, s[32:35], 0 offen offset:512
    buffer_load_dwordx4 v[52:55], v6, s[32:35], 0 offen offset:576
    buffer_load_dwordx4 v[56:59], v6, s[32:35], 0 offen offset:640
    buffer_load_dwordx4 v[60:63], v6, s[32:35], 0 offen offset:704
    buffer_load_dwordx4 v[64:67], v6, s[32:35], 0 offen offset:768
    buffer_load_dwordx4 v[68:71], v6, s[32:35], 0 offen offset:832
    buffer_load_dwordx4 v[72:75], v6, s[32:35], 0 offen offset:896
    buffer_load_dwordx4 v[76:79], v6, s[32:35], 0 offen offset:960
    s_waitcnt vmcnt(0)
    s_barrier
    s_mul_i32 s45, s43, 16640
    s_movk_i32 s46, 1040
    v_mul_lo_u32 v7, v3, s46
    v_lshl_add_u32 v7, v4, 4, v7
    v_add_u32 v7, s45, v7
    ds_read_b128 v[80:83], v7 offset:0
    ds_read_b128 v[84:87], v7 offset:64
    ds_read_b128 v[88:91], v7 offset:128
    ds_read_b128 v[92:95], v7 offset:192
    ds_read_b128 v[96:99], v7 offset:256
    ds_read_b128 v[100:103], v7 offset:320
    ds_read_b128 v[104:107], v7 offset:384
    ds_read_b128 v[108:111], v7 offset:448
    ds_read_b128 v[112:115], v7 offset:512
    ds_read_b128 v[116:119], v7 offset:576
    ds_read_b128 v[120:123], v7 offset:640
    ds_read_b128 v[124:127], v7 offset:704
    ds_read_b128 v[128:131], v7 offset:768
    ds_read_b128 v[132:135], v7 offset:832
    ds_read_b128 v[136:139], v7 offset:896
    ds_read_b128 v[140:143], v7 offset:960
    v_mov_b32 v208, 0
    v_mov_b32 v209, 0
    v_mov_b32 v210, 0
    v_mov_b32 v211, 0
    s_nop 1
    s_waitcnt lgkmcnt(15)
    v_mfma_f32_16x16x32_bf16 v[208:211], v[80:83], v[16:19], v[208:211]
    s_waitcnt lgkmcnt(14)
    v_mfma_f32_16x16x32_bf16 v[208:211], v[84:87], v[20:23], v[208:211]
    s_waitcnt lgkmcnt(13)
    v_mfma_f32_16x16x32_bf16 v[208:211], v[88:91], v[24:27], v[208:211]
    s_waitcnt lgkmcnt(12)
    v_mfma_f32_16x16x32_bf16 v[208:211], v[92:95], v[28:31], v[208:211]
    s_waitcnt lgkmcnt(11)
    v_mfma_f32_16x16x32_bf16 v[208:211], v[96:99], v[32:35], v[208:211]
    s_waitcnt lgkmcnt(10)
    v_mfma_f32_16x16x32_bf16 v[208:211], v[100:103], v[36:39], v[208:211]
    s_waitcnt lgkmcnt(9)
    v_mfma_f32_16x16x32_bf16 v[208:211], v[104:107], v[40:43], v[208:211]
    s_waitcnt lgkmcnt(8)
    v_mfma_f32_16x16x32_bf16 v[208:211], v[108:111], v[44:47], v[208:211]
    s_waitcnt lgkmcnt(7)
    v_mfma_f32_16x16x32_bf16 v[208:211], v[112:115], v[48:51], v[208:211]
    s_waitcnt lgkmcnt(6)
    v_mfma_f32_16x16x32_bf16 v[208:211], v[116:119], v[52:55], v[208:211]
    s_waitcnt lgkmcnt(5)
    v_mfma_f32_16x16x32_bf16 v[208:211], v[120:123], v[56:59], v[208:211]
    s_waitcnt lgkmcnt(4)
    v_mfma_f32_16x16x32_bf16 v[208:211], v[124:127], v[60:63], v[208:211]
    s_waitcnt lgkmcnt(3)
    v_mfma_f32_16x16x32_bf16 v[208:211], v[128:131], v[64:67], v[208:211]
    s_waitcnt lgkmcnt(2)
    v_mfma_f32_16x16x32_bf16 v[208:211], v[132:135], v[68:71], v[208:211]
    s_waitcnt lgkmcnt(1)
    v_mfma_f32_16x16x32_bf16 v[208:211], v[136:139], v[72:75], v[208:211]
    s_waitcnt lgkmcnt(0)
    v_mfma_f32_16x16x32_bf16 v[208:211], v[140:143], v[76:79], v[208:211]
    s_nop 7
    s_nop 1
    v_max_f32 v216, v208, v209
    v_max3_f32 v216, v216, v210, v211
    ds_swizzle_b32 v217, v216 offset:0x401f
    s_waitcnt lgkmcnt(0)
    v_max_f32 v216, v216, v217
    v_mov_b32 v217, v216
    s_nop 1
    v_permlane32_swap_b32 v216, v217
    v_max_f32 v216, v216, v217
    s_lshl_b32 s45, s43, 6
    s_add_u32 s45, s45, 66560
    v_lshlrev_b32 v218, 2, v3
    v_add_u32 v219, s45, v218
    ds_write_b32 v219, v216
    s_waitcnt lgkmcnt(0)
    s_barrier
    v_add_u32 v219, 66560, v218
    ds_read_b32 v220, v219 offset:0
    ds_read_b32 v221, v219 offset:64
    ds_read_b32 v222, v219 offset:128
    ds_read_b32 v223, v219 offset:192
    s_waitcnt lgkmcnt(0)
    v_max_f32 v216, v220, v221
    v_max3_f32 v216, v216, v222, v223
    v_sub_f32 v208, v208, v216
    v_exp_f32 v208, v208
    v_sub_f32 v209, v209, v216
    v_exp_f32 v209, v209
    v_sub_f32 v210, v210, v216
    v_exp_f32 v210, v210
    v_sub_f32 v211, v211, v216
    v_exp_f32 v211, v211
    s_nop 0
    v_add_f32 v217, v208, v209
    v_add_f32 v217, v217, v210
    v_add_f32 v217, v217, v211
    ds_swizzle_b32 v220, v217 offset:0x401f
    s_waitcnt lgkmcnt(0)
    v_add_f32 v217, v217, v220
    v_mov_b32 v220, v217
    s_nop 1
    v_permlane32_swap_b32 v217, v220
    v_add_f32 v217, v217, v220
    s_lshl_b32 s45, s43, 6
    s_add_u32 s45, s45, 66816
    v_add_u32 v219, s45, v218
    ds_write_b32 v219, v217
    v_cvt_pk_bf16_f32 v224, v208, v209
    v_cvt_pk_bf16_f32 v225, v210, v211
    s_lshl_b32 s45, s43, 9
    s_add_u32 s45, s45, 67072
    v_lshlrev_b32 v219, 3, v1
    v_add_u32 v219, s45, v219
    ds_write_b64 v219, v[224:225]
    s_waitcnt lgkmcnt(0)
    s_barrier
    v_lshlrev_b32 v219, 3, v1
    v_add_u32 v219, 67072, v219
    ds_read_b64 v[224:225], v219 offset:0
    ds_read_b64 v[226:227], v219 offset:512
    ds_read_b64 v[228:229], v219 offset:1024
    ds_read_b64 v[230:231], v219 offset:1536
    v_add_u32 v219, 66816, v218
    ds_read_b32 v240, v219 offset:0
    ds_read_b32 v241, v219 offset:64
    ds_read_b32 v242, v219 offset:128
    ds_read_b32 v243, v219 offset:192
    v_lshrrev_b32 v8, 2, v3
    v_lshl_add_u32 v8, v4, 2, v8
    v_mul_lo_u32 v8, v8, s46
    v_and_b32 v9, 3, v1
    v_lshl_add_u32 v8, v9, 3, v8
    s_lshl_b32 s45, s43, 8
    v_add_u32 v8, s45, v8
    v_mov_b32 v80, 0
    v_mov_b32 v81, 0
    v_mov_b32 v82, 0
    v_mov_b32 v83, 0
    v_mov_b32 v84, 0
    v_mov_b32 v85, 0
    v_mov_b32 v86, 0
    v_mov_b32 v87, 0
    v_mov_b32 v88, 0
    v_mov_b32 v89, 0
    v_mov_b32 v90, 0
    v_mov_b32 v91, 0
    v_mov_b32 v92, 0
    v_mov_b32 v93, 0
    v_mov_b32 v94, 0
    v_mov_b32 v95, 0
    v_mov_b32 v96, 0
    v_mov_b32 v97, 0
    v_mov_b32 v98, 0
    v_mov_b32 v99, 0
    v_mov_b32 v100, 0
    v_mov_b32 v101, 0
    v_mov_b32 v102, 0
    v_mov_b32 v103, 0
    v_mov_b32 v104, 0
    v_mov_b32 v105, 0
    v_mov_b32 v106, 0
    v_mov_b32 v107, 0
    v_mov_b32 v108, 0
    v_mov_b32 v109, 0
    v_mov_b32 v110, 0
    v_mov_b32 v111, 0
    s_waitcnt lgkmcnt(0)
    v_add_f32 v240, v240, v241
    v_add_f32 v242, v242, v243
    v_add_f32 v240, v240, v242
    ds_read_b64_tr_b16 v[112:113], v8 offset:0
    ds_read_b64_tr_b16 v[114:115], v8 offset:16640
    ds_read_b64_tr_b16 v[116:117], v8 offset:33280
    ds_read_b64_tr_b16 v[118:119], v8 offset:49920
    ds_read_b64_tr_b16 v[120:121], v8 offset:32
    ds_read_b64_tr_b16 v[122:123], v8 offset:16672
    ds_read_b64_tr_b16 v[124:125], v8 offset:33312
    ds_read_b64_tr_b16 v[126:127], v8 offset:49952
    ds_read_b64_tr_b16 v[128:129], v8 offset:64
    ds_read_b64_tr_b16 v[130:131], v8 offset:16704
    ds_read_b64_tr_b16 v[132:133], v8 offset:33344
    ds_read_b64_tr_b16 v[134:135], v8 offset:49984
    ds_read_b64_tr_b16 v[136:137], v8 offset:96
    ds_read_b64_tr_b16 v[138:139], v8 offset:16736
    ds_read_b64_tr_b16 v[140:141], v8 offset:33376
    ds_read_b64_tr_b16 v[142:143], v8 offset:50016
    ds_read_b64_tr_b16 v[144:145], v8 offset:128
    ds_read_b64_tr_b16 v[146:147], v8 offset:16768
    ds_read_b64_tr_b16 v[148:149], v8 offset:33408
    ds_read_b64_tr_b16 v[150:151], v8 offset:50048
    ds_read_b64_tr_b16 v[152:153], v8 offset:160
    ds_read_b64_tr_b16 v[154:155], v8 offset:16800
    ds_read_b64_tr_b16 v[156:157], v8 offset:33440
    ds_read_b64_tr_b16 v[158:159], v8 offset:50080
    ds_read_b64_tr_b16 v[160:161], v8 offset:192
    ds_read_b64_tr_b16 v[162:163], v8 offset:16832
    ds_read_b64_tr_b16 v[164:165], v8 offset:33472
    ds_read_b64_tr_b16 v[166:167], v8 offset:50112
    ds_read_b64_tr_b16 v[168:169], v8 offset:224
    ds_read_b64_tr_b16 v[170:171], v8 offset:16864
    ds_read_b64_tr_b16 v[172:173], v8 offset:33504
    ds_read_b64_tr_b16 v[174:175], v8 offset:50144
    s_waitcnt lgkmcnt(15)
    v_mfma_f32_16x16x32_bf16 v[80:83], v[112:115], v[224:227], v[80:83]
    v_mfma_f32_16x16x32_bf16 v[80:83], v[116:119], v[228:231], v[80:83]
    s_waitcnt lgkmcnt(15)
    v_mfma_f32_16x16x32_bf16 v[84:87], v[120:123], v[224:227], v[84:87]
    v_mfma_f32_16x16x32_bf16 v[84:87], v[124:127], v[228:231], v[84:87]
    s_waitcnt lgkmcnt(15)
    v_mfma_f32_16x16x32_bf16 v[88:91], v[128:131], v[224:227], v[88:91]
    v_mfma_f32_16x16x32_bf16 v[88:91], v[132:135], v[228:231], v[88:91]
    s_waitcnt lgkmcnt(15)
    v_mfma_f32_16x16x32_bf16 v[92:95], v[136:139], v[224:227], v[92:95]
    v_mfma_f32_16x16x32_bf16 v[92:95], v[140:143], v[228:231], v[92:95]
    s_waitcnt lgkmcnt(12)
    v_mfma_f32_16x16x32_bf16 v[96:99], v[144:147], v[224:227], v[96:99]
    v_mfma_f32_16x16x32_bf16 v[96:99], v[148:151], v[228:231], v[96:99]
    s_waitcnt lgkmcnt(8)
    v_mfma_f32_16x16x32_bf16 v[100:103], v[152:155], v[224:227], v[100:103]
    v_mfma_f32_16x16x32_bf16 v[100:103], v[156:159], v[228:231], v[100:103]
    s_waitcnt lgkmcnt(4)
    v_mfma_f32_16x16x32_bf16 v[104:107], v[160:163], v[224:227], v[104:107]
    v_mfma_f32_16x16x32_bf16 v[104:107], v[164:167], v[228:231], v[104:107]
    s_waitcnt lgkmcnt(0)
    v_mfma_f32_16x16x32_bf16 v[108:111], v[168:171], v[224:227], v[108:111]
    v_mfma_f32_16x16x32_bf16 v[108:111], v[172:175], v[228:231], v[108:111]
    s_nop 7
    s_nop 1
    s_lshl_b32 s45, s41, 15
    s_lshl_b32 s47, s42, 14
    s_add_u32 s45, s45, s47
    s_lshl_b32 s47, s43, 8
    s_add_u32 s45, s45, s47
    s_add_u32 s45, s45, 0x100000
    v_lshlrev_b32 v10, 10, v3
    v_lshl_add_u32 v10, v4, 3, v10
    v_add_u32 v10, s45, v10
    v_cvt_pk_bf16_f32 v112, v80, v81
    v_cvt_pk_bf16_f32 v113, v82, v83
    buffer_store_dwordx2 v[112:113], v10, s[32:35], 0 offen offset:0
    v_cvt_pk_bf16_f32 v114, v84, v85
    v_cvt_pk_bf16_f32 v115, v86, v87
    buffer_store_dwordx2 v[114:115], v10, s[32:35], 0 offen offset:32
    v_cvt_pk_bf16_f32 v116, v88, v89
    v_cvt_pk_bf16_f32 v117, v90, v91
    buffer_store_dwordx2 v[116:117], v10, s[32:35], 0 offen offset:64
    v_cvt_pk_bf16_f32 v118, v92, v93
    v_cvt_pk_bf16_f32 v119, v94, v95
    buffer_store_dwordx2 v[118:119], v10, s[32:35], 0 offen offset:96
    v_cvt_pk_bf16_f32 v120, v96, v97
    v_cvt_pk_bf16_f32 v121, v98, v99
    buffer_store_dwordx2 v[120:121], v10, s[32:35], 0 offen offset:128
    v_cvt_pk_bf16_f32 v122, v100, v101
    v_cvt_pk_bf16_f32 v123, v102, v103
    buffer_store_dwordx2 v[122:123], v10, s[32:35], 0 offen offset:160
    v_cvt_pk_bf16_f32 v124, v104, v105
    v_cvt_pk_bf16_f32 v125, v106, v107
    buffer_store_dwordx2 v[124:125], v10, s[32:35], 0 offen offset:192
    v_cvt_pk_bf16_f32 v126, v108, v109
    v_cvt_pk_bf16_f32 v127, v110, v111
    buffer_store_dwordx2 v[126:127], v10, s[32:35], 0 offen offset:224
    v_cmp_gt_u32 vcc, 16, v0
    s_and_saveexec_b64 s[48:49], vcc
    s_lshl_b32 s45, s42, 13
    s_lshl_b32 s47, s41, 2
    s_add_u32 s45, s45, s47
    v_lshlrev_b32 v10, 9, v0
    v_add_u32 v10, s45, v10
    v_add_u32 v11, 0x28000, v10
    buffer_store_dword v216, v11, s[32:35], 0 offen
    v_add_u32 v11, 0x2c000, v10
    buffer_store_dword v240, v11, s[32:35], 0 offen
    s_waitcnt vmcnt(0)
K3_END:
    s_endpgm

.globl k4_kernel
.p2align 8
.type k4_kernel,@function
k4_kernel:
    s_cmp_ge_u32 s2, 256
    s_cbranch_scc1 K4_END
    s_load_dwordx2 s[4:5], s[0:1], 32
    s_load_dwordx2 s[10:11], s[0:1], 104
    s_waitcnt lgkmcnt(0)
    s_mov_b32 s20, s4
    s_and_b32 s21, s5, 0xffff
    s_mov_b32 s22, 0x400000
    s_mov_b32 s23, 0x00020000
    s_mov_b32 s32, s10
    s_and_b32 s33, s11, 0xffff
    s_mov_b32 s34, 0x800000
    s_mov_b32 s35, 0x00020000
    s_lshr_b32 s41, s2, 3
    s_and_b32 s42, s2, 7
    v_and_b32 v1, 63, v0
    v_and_b32 v3, 15, v0
    v_lshrrev_b32 v4, 4, v0
    s_lshl_b32 s43, s41, 9
    v_lshlrev_b32 v5, 2, v1
    v_add_u32 v5, s43, v5
    v_add_u32 v6, 0x28000, v5
    buffer_load_dword v10, v6, s[32:35], 0 offen
    buffer_load_dword v12, v6, s[32:35], 0 offen offset:256
    v_add_u32 v6, 0x2c000, v5
    buffer_load_dword v11, v6, s[32:35], 0 offen
    buffer_load_dword v13, v6, s[32:35], 0 offen offset:256
    v_and_b32 v7, 7, v0
    v_lshrrev_b32 v8, 3, v0
    s_lshl_b32 s43, s41, 10
    s_lshl_b32 s44, s42, 7
    s_add_u32 s43, s43, s44
    s_add_u32 s43, s43, 0x100000
    v_lshlrev_b32 v6, 17, v8
    v_lshl_add_u32 v6, v7, 4, v6
    v_add_u32 v6, s43, v6
    s_mov_b32 s50, 0x8000
    s_mov_b32 s51, 0x10000
    s_mov_b32 s52, 0x18000
    buffer_load_dwordx4 v[16:19], v6, s[32:35], 0 offen
    buffer_load_dwordx4 v[20:23], v6, s[32:35], s50 offen
    buffer_load_dwordx4 v[24:27], v6, s[32:35], s51 offen
    buffer_load_dwordx4 v[28:31], v6, s[32:35], s52 offen
    s_lshl_b32 s43, s42, 19
    s_lshl_b32 s44, s41, 8
    s_add_u32 s43, s43, s44
    v_lshlrev_b32 v6, 15, v4
    v_lshl_add_u32 v6, v3, 4, v6
    v_add_u32 v6, s43, v6
    s_movk_i32 s53, 8192
    s_movk_i32 s54, 16384
    s_movk_i32 s55, 24576
    buffer_load_dwordx4 v[32:35], v6, s[20:23], 0 offen
    buffer_load_dwordx4 v[36:39], v6, s[20:23], s53 offen
    buffer_load_dwordx4 v[40:43], v6, s[20:23], s54 offen
    buffer_load_dwordx4 v[44:47], v6, s[20:23], s55 offen
    s_waitcnt vmcnt(8)
    v_max_f32 v100, v10, v12
    ds_swizzle_b32 v101, v100 offset:0x41f
    s_waitcnt lgkmcnt(0)
    v_max_f32 v100, v100, v101
    ds_swizzle_b32 v101, v100 offset:0x81f
    s_waitcnt lgkmcnt(0)
    v_max_f32 v100, v100, v101
    ds_swizzle_b32 v101, v100 offset:0x101f
    s_waitcnt lgkmcnt(0)
    v_max_f32 v100, v100, v101
    ds_swizzle_b32 v101, v100 offset:0x201f
    s_waitcnt lgkmcnt(0)
    v_max_f32 v100, v100, v101
    ds_swizzle_b32 v101, v100 offset:0x401f
    s_waitcnt lgkmcnt(0)
    v_max_f32 v100, v100, v101
    v_mov_b32 v101, v100
    s_nop 1
    v_permlane32_swap_b32 v100, v101
    v_max_f32 v100, v100, v101
    v_sub_f32 v10, v10, v100
    v_sub_f32 v12, v12, v100
    v_exp_f32 v10, v10
    v_exp_f32 v12, v12
    s_nop 0
    v_mul_f32 v100, v10, v11
    v_fmac_f32 v100, v12, v13
    ds_swizzle_b32 v101, v100 offset:0x41f
    s_waitcnt lgkmcnt(0)
    v_add_f32 v100, v100, v101
    ds_swizzle_b32 v101, v100 offset:0x81f
    s_waitcnt lgkmcnt(0)
    v_add_f32 v100, v100, v101
    ds_swizzle_b32 v101, v100 offset:0x101f
    s_waitcnt lgkmcnt(0)
    v_add_f32 v100, v100, v101
    ds_swizzle_b32 v101, v100 offset:0x201f
    s_waitcnt lgkmcnt(0)
    v_add_f32 v100, v100, v101
    ds_swizzle_b32 v101, v100 offset:0x401f
    s_waitcnt lgkmcnt(0)
    v_add_f32 v100, v100, v101
    v_mov_b32 v101, v100
    s_nop 1
    v_permlane32_swap_b32 v100, v101
    v_add_f32 v100, v100, v101
    v_rcp_f32 v100, v100
    s_nop 0
    v_mul_f32 v10, v10, v100
    v_mul_f32 v12, v12, v100
    v_and_b32 v101, 15, v8
    v_lshlrev_b32 v101, 4, v101
    v_cmp_gt_u32 vcc, 128, v0
    s_nop 1
    v_cndmask_b32 v14, v12, v10, vcc
    v_add_u32 v102, 0, v101
    ds_bpermute_b32 v48, v102, v14
    v_add_u32 v102, 4, v101
    ds_bpermute_b32 v49, v102, v14
    v_add_u32 v102, 8, v101
    ds_bpermute_b32 v50, v102, v14
    v_add_u32 v102, 12, v101
    ds_bpermute_b32 v51, v102, v14
    v_mov_b32 v52, 0
    v_mov_b32 v53, 0
    v_mov_b32 v54, 0
    v_mov_b32 v55, 0
    v_mov_b32 v56, 0
    v_mov_b32 v57, 0
    v_mov_b32 v58, 0
    v_mov_b32 v59, 0
    s_waitcnt vmcnt(4) lgkmcnt(0)
    v_lshlrev_b32 v102, 16, v16
    v_fmac_f32 v52, v48, v102
    v_and_b32 v102, 0xffff0000, v16
    v_fmac_f32 v53, v48, v102
    v_lshlrev_b32 v102, 16, v17
    v_fmac_f32 v54, v48, v102
    v_and_b32 v102, 0xffff0000, v17
    v_fmac_f32 v55, v48, v102
    v_lshlrev_b32 v102, 16, v18
    v_fmac_f32 v56, v48, v102
    v_and_b32 v102, 0xffff0000, v18
    v_fmac_f32 v57, v48, v102
    v_lshlrev_b32 v102, 16, v19
    v_fmac_f32 v58, v48, v102
    v_and_b32 v102, 0xffff0000, v19
    v_fmac_f32 v59, v48, v102
    v_lshlrev_b32 v102, 16, v20
    v_fmac_f32 v52, v49, v102
    v_and_b32 v102, 0xffff0000, v20
    v_fmac_f32 v53, v49, v102
    v_lshlrev_b32 v102, 16, v21
    v_fmac_f32 v54, v49, v102
    v_and_b32 v102, 0xffff0000, v21
    v_fmac_f32 v55, v49, v102
    v_lshlrev_b32 v102, 16, v22
    v_fmac_f32 v56, v49, v102
    v_and_b32 v102, 0xffff0000, v22
    v_fmac_f32 v57, v49, v102
    v_lshlrev_b32 v102, 16, v23
    v_fmac_f32 v58, v49, v102
    v_and_b32 v102, 0xffff0000, v23
    v_fmac_f32 v59, v49, v102
    v_lshlrev_b32 v102, 16, v24
    v_fmac_f32 v52, v50, v102
    v_and_b32 v102, 0xffff0000, v24
    v_fmac_f32 v53, v50, v102
    v_lshlrev_b32 v102, 16, v25
    v_fmac_f32 v54, v50, v102
    v_and_b32 v102, 0xffff0000, v25
    v_fmac_f32 v55, v50, v102
    v_lshlrev_b32 v102, 16, v26
    v_fmac_f32 v56, v50, v102
    v_and_b32 v102, 0xffff0000, v26
    v_fmac_f32 v57, v50, v102
    v_lshlrev_b32 v102, 16, v27
    v_fmac_f32 v58, v50, v102
    v_and_b32 v102, 0xffff0000, v27
    v_fmac_f32 v59, v50, v102
    v_lshlrev_b32 v102, 16, v28
    v_fmac_f32 v52, v51, v102
    v_and_b32 v102, 0xffff0000, v28
    v_fmac_f32 v53, v51, v102
    v_lshlrev_b32 v102, 16, v29
    v_fmac_f32 v54, v51, v102
    v_and_b32 v102, 0xffff0000, v29
    v_fmac_f32 v55, v51, v102
    v_lshlrev_b32 v102, 16, v30
    v_fmac_f32 v56, v51, v102
    v_and_b32 v102, 0xffff0000, v30
    v_fmac_f32 v57, v51, v102
    v_lshlrev_b32 v102, 16, v31
    v_fmac_f32 v58, v51, v102
    v_and_b32 v102, 0xffff0000, v31
    v_fmac_f32 v59, v51, v102
    v_lshlrev_b32 v101, 8, v8
    v_lshl_add_u32 v101, v7, 5, v101
    ds_write_b128 v101, v[52:55]
    ds_write_b128 v101, v[56:59] offset:16
    s_waitcnt lgkmcnt(0)
    s_barrier
    v_lshlrev_b32 v101, 2, v1
    ds_read_b32 v64, v101 offset:0
    ds_read_b32 v65, v101 offset:256
    ds_read_b32 v66, v101 offset:512
    ds_read_b32 v67, v101 offset:768
    ds_read_b32 v68, v101 offset:1024
    ds_read_b32 v69, v101 offset:1280
    ds_read_b32 v70, v101 offset:1536
    ds_read_b32 v71, v101 offset:1792
    ds_read_b32 v72, v101 offset:2048
    ds_read_b32 v73, v101 offset:2304
    ds_read_b32 v74, v101 offset:2560
    ds_read_b32 v75, v101 offset:2816
    ds_read_b32 v76, v101 offset:3072
    ds_read_b32 v77, v101 offset:3328
    ds_read_b32 v78, v101 offset:3584
    ds_read_b32 v79, v101 offset:3840
    ds_read_b32 v80, v101 offset:4096
    ds_read_b32 v81, v101 offset:4352
    ds_read_b32 v82, v101 offset:4608
    ds_read_b32 v83, v101 offset:4864
    ds_read_b32 v84, v101 offset:5120
    ds_read_b32 v85, v101 offset:5376
    ds_read_b32 v86, v101 offset:5632
    ds_read_b32 v87, v101 offset:5888
    ds_read_b32 v88, v101 offset:6144
    ds_read_b32 v89, v101 offset:6400
    ds_read_b32 v90, v101 offset:6656
    ds_read_b32 v91, v101 offset:6912
    ds_read_b32 v92, v101 offset:7168
    ds_read_b32 v93, v101 offset:7424
    ds_read_b32 v94, v101 offset:7680
    ds_read_b32 v95, v101 offset:7936
    s_waitcnt lgkmcnt(0)
    v_add_f32 v64, v64, v65
    v_add_f32 v64, v64, v66
    v_add_f32 v64, v64, v67
    v_add_f32 v64, v64, v68
    v_add_f32 v64, v64, v69
    v_add_f32 v64, v64, v70
    v_add_f32 v64, v64, v71
    v_add_f32 v64, v64, v72
    v_add_f32 v64, v64, v73
    v_add_f32 v64, v64, v74
    v_add_f32 v64, v64, v75
    v_add_f32 v64, v64, v76
    v_add_f32 v64, v64, v77
    v_add_f32 v64, v64, v78
    v_add_f32 v64, v64, v79
    v_add_f32 v64, v64, v80
    v_add_f32 v64, v64, v81
    v_add_f32 v64, v64, v82
    v_add_f32 v64, v64, v83
    v_add_f32 v64, v64, v84
    v_add_f32 v64, v64, v85
    v_add_f32 v64, v64, v86
    v_add_f32 v64, v64, v87
    v_add_f32 v64, v64, v88
    v_add_f32 v64, v64, v89
    v_add_f32 v64, v64, v90
    v_add_f32 v64, v64, v91
    v_add_f32 v64, v64, v92
    v_add_f32 v64, v64, v93
    v_add_f32 v64, v64, v94
    v_add_f32 v64, v64, v95
    ds_write_b32 v101, v64 offset:8192
    s_waitcnt lgkmcnt(0)
    s_barrier
    v_lshlrev_b32 v101, 4, v4
    ds_read_b128 v[64:67], v101 offset:8192
    v_mov_b32 v52, 0
    v_mov_b32 v53, 0
    v_mov_b32 v54, 0
    v_mov_b32 v55, 0
    v_mov_b32 v56, 0
    v_mov_b32 v57, 0
    v_mov_b32 v58, 0
    v_mov_b32 v59, 0
    s_waitcnt vmcnt(0) lgkmcnt(0)
    v_lshlrev_b32 v102, 16, v32
    v_fmac_f32 v52, v64, v102
    v_and_b32 v102, 0xffff0000, v32
    v_fmac_f32 v53, v64, v102
    v_lshlrev_b32 v102, 16, v33
    v_fmac_f32 v54, v64, v102
    v_and_b32 v102, 0xffff0000, v33
    v_fmac_f32 v55, v64, v102
    v_lshlrev_b32 v102, 16, v34
    v_fmac_f32 v56, v64, v102
    v_and_b32 v102, 0xffff0000, v34
    v_fmac_f32 v57, v64, v102
    v_lshlrev_b32 v102, 16, v35
    v_fmac_f32 v58, v64, v102
    v_and_b32 v102, 0xffff0000, v35
    v_fmac_f32 v59, v64, v102
    v_lshlrev_b32 v102, 16, v36
    v_fmac_f32 v52, v65, v102
    v_and_b32 v102, 0xffff0000, v36
    v_fmac_f32 v53, v65, v102
    v_lshlrev_b32 v102, 16, v37
    v_fmac_f32 v54, v65, v102
    v_and_b32 v102, 0xffff0000, v37
    v_fmac_f32 v55, v65, v102
    v_lshlrev_b32 v102, 16, v38
    v_fmac_f32 v56, v65, v102
    v_and_b32 v102, 0xffff0000, v38
    v_fmac_f32 v57, v65, v102
    v_lshlrev_b32 v102, 16, v39
    v_fmac_f32 v58, v65, v102
    v_and_b32 v102, 0xffff0000, v39
    v_fmac_f32 v59, v65, v102
    v_lshlrev_b32 v102, 16, v40
    v_fmac_f32 v52, v66, v102
    v_and_b32 v102, 0xffff0000, v40
    v_fmac_f32 v53, v66, v102
    v_lshlrev_b32 v102, 16, v41
    v_fmac_f32 v54, v66, v102
    v_and_b32 v102, 0xffff0000, v41
    v_fmac_f32 v55, v66, v102
    v_lshlrev_b32 v102, 16, v42
    v_fmac_f32 v56, v66, v102
    v_and_b32 v102, 0xffff0000, v42
    v_fmac_f32 v57, v66, v102
    v_lshlrev_b32 v102, 16, v43
    v_fmac_f32 v58, v66, v102
    v_and_b32 v102, 0xffff0000, v43
    v_fmac_f32 v59, v66, v102
    v_lshlrev_b32 v102, 16, v44
    v_fmac_f32 v52, v67, v102
    v_and_b32 v102, 0xffff0000, v44
    v_fmac_f32 v53, v67, v102
    v_lshlrev_b32 v102, 16, v45
    v_fmac_f32 v54, v67, v102
    v_and_b32 v102, 0xffff0000, v45
    v_fmac_f32 v55, v67, v102
    v_lshlrev_b32 v102, 16, v46
    v_fmac_f32 v56, v67, v102
    v_and_b32 v102, 0xffff0000, v46
    v_fmac_f32 v57, v67, v102
    v_lshlrev_b32 v102, 16, v47
    v_fmac_f32 v58, v67, v102
    v_and_b32 v102, 0xffff0000, v47
    v_fmac_f32 v59, v67, v102
    v_lshlrev_b32 v101, 9, v4
    v_lshl_add_u32 v101, v3, 5, v101
    ds_write_b128 v101, v[52:55] offset:12288
    ds_write_b128 v101, v[56:59] offset:12304
    s_waitcnt lgkmcnt(0)
    s_barrier
    v_cmp_gt_u32 vcc, 128, v0
    s_and_saveexec_b64 s[48:49], vcc
    s_cbranch_execz K4_END
    v_lshlrev_b32 v101, 2, v0
    ds_read_b32 v64, v101 offset:12288
    ds_read_b32 v65, v101 offset:12800
    ds_read_b32 v66, v101 offset:13312
    ds_read_b32 v67, v101 offset:13824
    ds_read_b32 v68, v101 offset:14336
    ds_read_b32 v69, v101 offset:14848
    ds_read_b32 v70, v101 offset:15360
    ds_read_b32 v71, v101 offset:15872
    ds_read_b32 v72, v101 offset:16384
    ds_read_b32 v73, v101 offset:16896
    ds_read_b32 v74, v101 offset:17408
    ds_read_b32 v75, v101 offset:17920
    ds_read_b32 v76, v101 offset:18432
    ds_read_b32 v77, v101 offset:18944
    ds_read_b32 v78, v101 offset:19456
    ds_read_b32 v79, v101 offset:19968
    s_waitcnt lgkmcnt(0)
    v_add_f32 v64, v64, v65
    v_add_f32 v64, v64, v66
    v_add_f32 v64, v64, v67
    v_add_f32 v64, v64, v68
    v_add_f32 v64, v64, v69
    v_add_f32 v64, v64, v70
    v_add_f32 v64, v64, v71
    v_add_f32 v64, v64, v72
    v_add_f32 v64, v64, v73
    v_add_f32 v64, v64, v74
    v_add_f32 v64, v64, v75
    v_add_f32 v64, v64, v76
    v_add_f32 v64, v64, v77
    v_add_f32 v64, v64, v78
    v_add_f32 v64, v64, v79
    s_lshl_b32 s43, s42, 14
    s_lshl_b32 s44, s41, 9
    s_add_u32 s43, s43, s44
    s_add_u32 s43, s43, 0x30000
    v_add_u32 v101, s43, v101
    buffer_store_dword v64, v101, s[32:35], 0 offen
    s_waitcnt vmcnt(0)
K4_END:
    s_endpgm

.globl k5_kernel
.p2align 8
.type k5_kernel,@function
k5_kernel:
    s_cmp_ge_u32 s2, 256
    s_cbranch_scc1 K5_END
    s_load_dwordx2 s[6:7], s[0:1], 40
    s_load_dwordx2 s[10:11], s[0:1], 104
    s_waitcnt lgkmcnt(0)
    s_mov_b32 s24, s6
    s_and_b32 s25, s7, 0xffff
    s_mov_b32 s26, 0x400000
    s_mov_b32 s27, 0x00020000
    s_mov_b32 s32, s10
    s_and_b32 s33, s11, 0xffff
    s_mov_b32 s34, 0x800000
    s_mov_b32 s35, 0x00020000
    s_lshr_b32 s41, s2, 3
    s_and_b32 s42, s2, 7
    v_and_b32 v7, 7, v0
    v_lshrrev_b32 v8, 3, v0
    s_lshl_b32 s43, s41, 17
    s_lshl_b32 s44, s42, 7
    s_add_u32 s43, s43, s44
    v_lshlrev_b32 v6, 12, v8
    v_lshl_add_u32 v6, v7, 4, v6
    v_add_u32 v6, s43, v6
    buffer_load_dwordx4 v[32:35], v6, s[24:27], 0 offen offset:0
    buffer_load_dwordx4 v[36:39], v6, s[24:27], 0 offen offset:1024
    buffer_load_dwordx4 v[40:43], v6, s[24:27], 0 offen offset:2048
    buffer_load_dwordx4 v[44:47], v6, s[24:27], 0 offen offset:3072
    v_and_b32 v29, 127, v0
    v_lshlrev_b32 v29, 2, v29
    s_lshl_b32 s44, s41, 9
    s_add_u32 s44, s44, 0x30000
    v_add_u32 v30, s44, v29
    s_mov_b32 s50, 0
    s_mov_b32 s51, 16384
    s_mov_b32 s52, 32768
    s_mov_b32 s53, 49152
    s_mov_b32 s54, 65536
    s_mov_b32 s55, 81920
    s_mov_b32 s56, 98304
    s_mov_b32 s57, 114688
    buffer_load_dword v48, v30, s[32:35], s50 offen
    buffer_load_dword v49, v30, s[32:35], s51 offen
    buffer_load_dword v50, v30, s[32:35], s52 offen
    buffer_load_dword v51, v30, s[32:35], s53 offen
    buffer_load_dword v52, v30, s[32:35], s54 offen
    buffer_load_dword v53, v30, s[32:35], s55 offen
    buffer_load_dword v54, v30, s[32:35], s56 offen
    buffer_load_dword v55, v30, s[32:35], s57 offen
    s_waitcnt vmcnt(0)
    v_add_f32 v48, v48, v49
    v_add_f32 v48, v48, v50
    v_add_f32 v48, v48, v51
    v_add_f32 v48, v48, v52
    v_add_f32 v48, v48, v53
    v_add_f32 v48, v48, v54
    v_add_f32 v48, v48, v55
    v_cvt_pk_bf16_f32 v48, v48, v48
    v_and_b32 v48, 0xffff, v48
    ds_write_b32 v29, v48
    s_waitcnt lgkmcnt(0)
    s_barrier
    v_lshlrev_b32 v29, 4, v8
    ds_read_b128 v[48:51], v29
    v_mov_b32 v52, 0
    v_mov_b32 v53, 0
    v_mov_b32 v54, 0
    v_mov_b32 v55, 0
    v_mov_b32 v56, 0
    v_mov_b32 v57, 0
    v_mov_b32 v58, 0
    v_mov_b32 v59, 0
    s_waitcnt lgkmcnt(0)
    v_lshlrev_b32 v30, 16, v48
    v_dot2c_f32_bf16 v52, v32, v48
    v_dot2c_f32_bf16 v53, v32, v30
    v_dot2c_f32_bf16 v54, v33, v48
    v_dot2c_f32_bf16 v55, v33, v30
    v_dot2c_f32_bf16 v56, v34, v48
    v_dot2c_f32_bf16 v57, v34, v30
    v_dot2c_f32_bf16 v58, v35, v48
    v_dot2c_f32_bf16 v59, v35, v30
    v_lshlrev_b32 v30, 16, v49
    v_dot2c_f32_bf16 v52, v36, v49
    v_dot2c_f32_bf16 v53, v36, v30
    v_dot2c_f32_bf16 v54, v37, v49
    v_dot2c_f32_bf16 v55, v37, v30
    v_dot2c_f32_bf16 v56, v38, v49
    v_dot2c_f32_bf16 v57, v38, v30
    v_dot2c_f32_bf16 v58, v39, v49
    v_dot2c_f32_bf16 v59, v39, v30
    v_lshlrev_b32 v30, 16, v50
    v_dot2c_f32_bf16 v52, v40, v50
    v_dot2c_f32_bf16 v53, v40, v30
    v_dot2c_f32_bf16 v54, v41, v50
    v_dot2c_f32_bf16 v55, v41, v30
    v_dot2c_f32_bf16 v56, v42, v50
    v_dot2c_f32_bf16 v57, v42, v30
    v_dot2c_f32_bf16 v58, v43, v50
    v_dot2c_f32_bf16 v59, v43, v30
    v_lshlrev_b32 v30, 16, v51
    v_dot2c_f32_bf16 v52, v44, v51
    v_dot2c_f32_bf16 v53, v44, v30
    v_dot2c_f32_bf16 v54, v45, v51
    v_dot2c_f32_bf16 v55, v45, v30
    v_dot2c_f32_bf16 v56, v46, v51
    v_dot2c_f32_bf16 v57, v46, v30
    v_dot2c_f32_bf16 v58, v47, v51
    v_dot2c_f32_bf16 v59, v47, v30
    v_lshlrev_b32 v29, 8, v8
    v_lshl_add_u32 v29, v7, 5, v29
    ds_write_b128 v29, v[52:55] offset:1024
    ds_write_b128 v29, v[56:59] offset:1040
    s_waitcnt lgkmcnt(0)
    s_barrier
    v_cmp_gt_u32 vcc, 64, v0
    s_and_saveexec_b64 s[48:49], vcc
    s_cbranch_execz K5_END
    v_lshlrev_b32 v29, 2, v0
    ds_read_b32 v64, v29 offset:1024
    ds_read_b32 v65, v29 offset:1280
    ds_read_b32 v66, v29 offset:1536
    ds_read_b32 v67, v29 offset:1792
    ds_read_b32 v68, v29 offset:2048
    ds_read_b32 v69, v29 offset:2304
    ds_read_b32 v70, v29 offset:2560
    ds_read_b32 v71, v29 offset:2816
    ds_read_b32 v72, v29 offset:3072
    ds_read_b32 v73, v29 offset:3328
    ds_read_b32 v74, v29 offset:3584
    ds_read_b32 v75, v29 offset:3840
    ds_read_b32 v76, v29 offset:4096
    ds_read_b32 v77, v29 offset:4352
    ds_read_b32 v78, v29 offset:4608
    ds_read_b32 v79, v29 offset:4864
    ds_read_b32 v80, v29 offset:5120
    ds_read_b32 v81, v29 offset:5376
    ds_read_b32 v82, v29 offset:5632
    ds_read_b32 v83, v29 offset:5888
    ds_read_b32 v84, v29 offset:6144
    ds_read_b32 v85, v29 offset:6400
    ds_read_b32 v86, v29 offset:6656
    ds_read_b32 v87, v29 offset:6912
    ds_read_b32 v88, v29 offset:7168
    ds_read_b32 v89, v29 offset:7424
    ds_read_b32 v90, v29 offset:7680
    ds_read_b32 v91, v29 offset:7936
    ds_read_b32 v92, v29 offset:8192
    ds_read_b32 v93, v29 offset:8448
    ds_read_b32 v94, v29 offset:8704
    ds_read_b32 v95, v29 offset:8960
    s_waitcnt lgkmcnt(0)
    v_add_f32 v64, v64, v65
    v_add_f32 v64, v64, v66
    v_add_f32 v64, v64, v67
    v_add_f32 v64, v64, v68
    v_add_f32 v64, v64, v69
    v_add_f32 v64, v64, v70
    v_add_f32 v64, v64, v71
    v_add_f32 v64, v64, v72
    v_add_f32 v64, v64, v73
    v_add_f32 v64, v64, v74
    v_add_f32 v64, v64, v75
    v_add_f32 v64, v64, v76
    v_add_f32 v64, v64, v77
    v_add_f32 v64, v64, v78
    v_add_f32 v64, v64, v79
    v_add_f32 v64, v64, v80
    v_add_f32 v64, v64, v81
    v_add_f32 v64, v64, v82
    v_add_f32 v64, v64, v83
    v_add_f32 v64, v64, v84
    v_add_f32 v64, v64, v85
    v_add_f32 v64, v64, v86
    v_add_f32 v64, v64, v87
    v_add_f32 v64, v64, v88
    v_add_f32 v64, v64, v89
    v_add_f32 v64, v64, v90
    v_add_f32 v64, v64, v91
    v_add_f32 v64, v64, v92
    v_add_f32 v64, v64, v93
    v_add_f32 v64, v64, v94
    v_add_f32 v64, v64, v95
    s_lshl_b32 s43, s41, 11
    s_lshl_b32 s44, s42, 8
    s_add_u32 s43, s43, s44
    s_add_u32 s43, s43, 0x50000
    v_add_u32 v29, s43, v29
    buffer_store_dword v64, v29, s[32:35], 0 offen
    s_waitcnt vmcnt(0)
K5_END:
    s_endpgm

.globl k6_kernel
.p2align 8
.type k6_kernel,@function
k6_kernel:
    s_cmp_ge_u32 s2, 16
    s_cbranch_scc1 K6_END
    s_load_dwordx2 s[4:5], s[0:1], 0
    s_load_dwordx2 s[6:7], s[0:1], 80
    s_load_dwordx2 s[8:9], s[0:1], 88
    s_load_dwordx2 s[10:11], s[0:1], 104
    s_waitcnt lgkmcnt(0)
    s_mov_b32 s20, s4
    s_and_b32 s21, s5, 0xffff
    s_mov_b32 s22, 0x400
    s_mov_b32 s23, 0x00020000
    s_mov_b32 s24, s6
    s_and_b32 s25, s7, 0xffff
    s_mov_b32 s26, 0x400
    s_mov_b32 s27, 0x00020000
    s_mov_b32 s28, s8
    s_and_b32 s29, s9, 0xffff
    s_mov_b32 s30, 0x400
    s_mov_b32 s31, 0x00020000
    s_mov_b32 s32, s10
    s_and_b32 s33, s11, 0xffff
    s_mov_b32 s34, 0x9b000
    s_mov_b32 s35, 0x00020000
    v_and_b32 v1, 7, v0
    v_lshrrev_b32 v2, 3, v0
    v_lshlrev_b32 v3, 2, v0
    buffer_load_dword v4, v3, s[20:23], 0 offen
    buffer_load_dword v5, v3, s[24:27], 0 offen
    s_lshl_b32 s43, s2, 7
    s_add_u32 s43, s43, 0x50000
    v_lshlrev_b32 v6, 11, v2
    v_lshl_add_u32 v6, v1, 4, v6
    v_add_u32 v6, s43, v6
    buffer_load_dwordx4 v[16:19], v6, s[32:35], 0 offen
    v_add_u32 v7, 0x20000, v6
    s_mov_b32 s50, 0x10000
    s_mov_b32 s51, 0x20000
    buffer_load_dwordx4 v[48:51], v7, s[32:35], 0 offen
    buffer_load_dwordx4 v[52:55], v7, s[32:35], s50 offen
    buffer_load_dwordx4 v[56:59], v7, s[32:35], s51 offen
    s_waitcnt vmcnt(0)
    v_add_f32 v48, v48, v52
    v_add_f32 v48, v48, v56
    v_add_f32 v49, v49, v53
    v_add_f32 v49, v49, v57
    v_add_f32 v50, v50, v54
    v_add_f32 v50, v50, v58
    v_add_f32 v51, v51, v55
    v_add_f32 v51, v51, v59
    v_lshlrev_b32 v8, 16, v4
    v_lshlrev_b32 v9, 16, v5
    v_mul_f32 v8, v8, v9
    v_and_b32 v10, 0xffff0000, v4
    v_and_b32 v11, 0xffff0000, v5
    v_mul_f32 v10, v10, v11
    v_cvt_pk_bf16_f32 v8, v8, v10
    v_lshlrev_b32 v9, 16, v8
    v_and_b32 v8, 0xffff0000, v8
    v_add_f32 v8, v8, v9
    ds_swizzle_b32 v9, v8 offset:0x41f
    s_waitcnt lgkmcnt(0)
    v_add_f32 v8, v8, v9
    ds_swizzle_b32 v9, v8 offset:0x81f
    s_waitcnt lgkmcnt(0)
    v_add_f32 v8, v8, v9
    ds_swizzle_b32 v9, v8 offset:0x101f
    s_waitcnt lgkmcnt(0)
    v_add_f32 v8, v8, v9
    ds_swizzle_b32 v9, v8 offset:0x201f
    s_waitcnt lgkmcnt(0)
    v_add_f32 v8, v8, v9
    ds_swizzle_b32 v9, v8 offset:0x401f
    s_waitcnt lgkmcnt(0)
    v_add_f32 v8, v8, v9
    v_mov_b32 v9, v8
    s_nop 1
    v_permlane32_swap_b32 v8, v9
    v_add_f32 v8, v8, v9
    v_lshlrev_b32 v12, 7, v2
    v_lshl_add_u32 v12, v1, 4, v12
    ds_write_b128 v12, v[16:19]
    ds_write_b128 v12, v[48:51] offset:4096
    v_lshrrev_b32 v13, 6, v0
    v_lshlrev_b32 v13, 2, v13
    ds_write_b32 v13, v8 offset:8192
    s_waitcnt lgkmcnt(0)
    s_barrier
    v_cmp_gt_u32 vcc, 32, v0
    s_and_saveexec_b64 s[48:49], vcc
    s_cbranch_execz K6_END
    v_lshlrev_b32 v12, 2, v0
    ds_read_b32 v16, v12 offset:0
    ds_read_b32 v17, v12 offset:128
    ds_read_b32 v18, v12 offset:256
    ds_read_b32 v19, v12 offset:384
    ds_read_b32 v20, v12 offset:512
    ds_read_b32 v21, v12 offset:640
    ds_read_b32 v22, v12 offset:768
    ds_read_b32 v23, v12 offset:896
    ds_read_b32 v24, v12 offset:1024
    ds_read_b32 v25, v12 offset:1152
    ds_read_b32 v26, v12 offset:1280
    ds_read_b32 v27, v12 offset:1408
    ds_read_b32 v28, v12 offset:1536
    ds_read_b32 v29, v12 offset:1664
    ds_read_b32 v30, v12 offset:1792
    ds_read_b32 v31, v12 offset:1920
    ds_read_b32 v32, v12 offset:2048
    ds_read_b32 v33, v12 offset:2176
    ds_read_b32 v34, v12 offset:2304
    ds_read_b32 v35, v12 offset:2432
    ds_read_b32 v36, v12 offset:2560
    ds_read_b32 v37, v12 offset:2688
    ds_read_b32 v38, v12 offset:2816
    ds_read_b32 v39, v12 offset:2944
    ds_read_b32 v40, v12 offset:3072
    ds_read_b32 v41, v12 offset:3200
    ds_read_b32 v42, v12 offset:3328
    ds_read_b32 v43, v12 offset:3456
    ds_read_b32 v44, v12 offset:3584
    ds_read_b32 v45, v12 offset:3712
    ds_read_b32 v46, v12 offset:3840
    ds_read_b32 v47, v12 offset:3968
    ds_read_b32 v48, v12 offset:4096
    ds_read_b32 v49, v12 offset:4224
    ds_read_b32 v50, v12 offset:4352
    ds_read_b32 v51, v12 offset:4480
    ds_read_b32 v52, v12 offset:4608
    ds_read_b32 v53, v12 offset:4736
    ds_read_b32 v54, v12 offset:4864
    ds_read_b32 v55, v12 offset:4992
    ds_read_b32 v56, v12 offset:5120
    ds_read_b32 v57, v12 offset:5248
    ds_read_b32 v58, v12 offset:5376
    ds_read_b32 v59, v12 offset:5504
    ds_read_b32 v60, v12 offset:5632
    ds_read_b32 v61, v12 offset:5760
    ds_read_b32 v62, v12 offset:5888
    ds_read_b32 v63, v12 offset:6016
    ds_read_b32 v64, v12 offset:6144
    ds_read_b32 v65, v12 offset:6272
    ds_read_b32 v66, v12 offset:6400
    ds_read_b32 v67, v12 offset:6528
    ds_read_b32 v68, v12 offset:6656
    ds_read_b32 v69, v12 offset:6784
    ds_read_b32 v70, v12 offset:6912
    ds_read_b32 v71, v12 offset:7040
    ds_read_b32 v72, v12 offset:7168
    ds_read_b32 v73, v12 offset:7296
    ds_read_b32 v74, v12 offset:7424
    ds_read_b32 v75, v12 offset:7552
    ds_read_b32 v76, v12 offset:7680
    ds_read_b32 v77, v12 offset:7808
    ds_read_b32 v78, v12 offset:7936
    ds_read_b32 v79, v12 offset:8064
    v_mov_b32 v13, 8192
    ds_read_b128 v[8:11], v13
    s_waitcnt lgkmcnt(0)
    v_add_f32 v16, v16, v17
    v_add_f32 v48, v48, v49
    v_add_f32 v16, v16, v18
    v_add_f32 v48, v48, v50
    v_add_f32 v16, v16, v19
    v_add_f32 v48, v48, v51
    v_add_f32 v16, v16, v20
    v_add_f32 v48, v48, v52
    v_add_f32 v16, v16, v21
    v_add_f32 v48, v48, v53
    v_add_f32 v16, v16, v22
    v_add_f32 v48, v48, v54
    v_add_f32 v16, v16, v23
    v_add_f32 v48, v48, v55
    v_add_f32 v16, v16, v24
    v_add_f32 v48, v48, v56
    v_add_f32 v16, v16, v25
    v_add_f32 v48, v48, v57
    v_add_f32 v16, v16, v26
    v_add_f32 v48, v48, v58
    v_add_f32 v16, v16, v27
    v_add_f32 v48, v48, v59
    v_add_f32 v16, v16, v28
    v_add_f32 v48, v48, v60
    v_add_f32 v16, v16, v29
    v_add_f32 v48, v48, v61
    v_add_f32 v16, v16, v30
    v_add_f32 v48, v48, v62
    v_add_f32 v16, v16, v31
    v_add_f32 v48, v48, v63
    v_add_f32 v16, v16, v32
    v_add_f32 v48, v48, v64
    v_add_f32 v16, v16, v33
    v_add_f32 v48, v48, v65
    v_add_f32 v16, v16, v34
    v_add_f32 v48, v48, v66
    v_add_f32 v16, v16, v35
    v_add_f32 v48, v48, v67
    v_add_f32 v16, v16, v36
    v_add_f32 v48, v48, v68
    v_add_f32 v16, v16, v37
    v_add_f32 v48, v48, v69
    v_add_f32 v16, v16, v38
    v_add_f32 v48, v48, v70
    v_add_f32 v16, v16, v39
    v_add_f32 v48, v48, v71
    v_add_f32 v16, v16, v40
    v_add_f32 v48, v48, v72
    v_add_f32 v16, v16, v41
    v_add_f32 v48, v48, v73
    v_add_f32 v16, v16, v42
    v_add_f32 v48, v48, v74
    v_add_f32 v16, v16, v43
    v_add_f32 v48, v48, v75
    v_add_f32 v16, v16, v44
    v_add_f32 v48, v48, v76
    v_add_f32 v16, v16, v45
    v_add_f32 v48, v48, v77
    v_add_f32 v16, v16, v46
    v_add_f32 v48, v48, v78
    v_add_f32 v16, v16, v47
    v_add_f32 v48, v48, v79
    v_add_f32 v8, v8, v9
    v_add_f32 v10, v10, v11
    v_add_f32 v8, v8, v10
    v_cvt_pk_bf16_f32 v8, v8, v8
    v_lshlrev_b32 v8, 16, v8
    v_mul_f32 v8, 0xbfb8aa3b, v8
    v_exp_f32 v8, v8
    s_nop 0
    v_add_f32 v8, 1.0, v8
    v_rcp_f32 v8, v8
    s_nop 0
    v_cvt_pk_bf16_f32 v8, v8, v8
    v_lshlrev_b32 v8, 16, v8
    v_sub_f32 v9, 1.0, v8
    v_cvt_pk_bf16_f32 v9, v9, v9
    v_lshlrev_b32 v9, 16, v9
    v_cvt_pk_bf16_f32 v16, v16, v48
    v_lshlrev_b32 v17, 16, v16
    v_and_b32 v18, 0xffff0000, v16
    v_mul_f32 v17, v8, v17
    v_mul_f32 v18, v9, v18
    v_cvt_pk_bf16_f32 v17, v17, v18
    v_lshlrev_b32 v18, 16, v17
    v_and_b32 v17, 0xffff0000, v17
    v_add_f32 v17, v17, v18
    v_cvt_pk_bf16_f32 v17, v17, v17
    s_lshl_b32 s43, s2, 6
    v_lshlrev_b32 v12, 1, v0
    v_add_u32 v12, s43, v12
    buffer_store_short v17, v12, s[28:31], 0 offen
    s_waitcnt vmcnt(0)
K6_END:
    s_endpgm

.section .rodata,"a"
.p2align 6
.amdhsa_kernel k1_kernel
  .amdhsa_next_free_vgpr 256
  .amdhsa_next_free_sgpr 102
  .amdhsa_accum_offset 256
  .amdhsa_group_segment_fixed_size 0
  .amdhsa_kernarg_size 112
  .amdhsa_user_sgpr_count 2
  .amdhsa_user_sgpr_kernarg_segment_ptr 1
  .amdhsa_system_sgpr_workgroup_id_x 1
.end_amdhsa_kernel

.p2align 6
.amdhsa_kernel k2_kernel
  .amdhsa_next_free_vgpr 256
  .amdhsa_next_free_sgpr 102
  .amdhsa_accum_offset 256
  .amdhsa_group_segment_fixed_size 0
  .amdhsa_kernarg_size 112
  .amdhsa_user_sgpr_count 2
  .amdhsa_user_sgpr_kernarg_segment_ptr 1
  .amdhsa_system_sgpr_workgroup_id_x 1
.end_amdhsa_kernel

.p2align 6
.amdhsa_kernel k3_kernel
  .amdhsa_next_free_vgpr 256
  .amdhsa_next_free_sgpr 102
  .amdhsa_accum_offset 256
  .amdhsa_group_segment_fixed_size 0
  .amdhsa_kernarg_size 112
  .amdhsa_user_sgpr_count 2
  .amdhsa_user_sgpr_kernarg_segment_ptr 1
  .amdhsa_system_sgpr_workgroup_id_x 1
.end_amdhsa_kernel

.p2align 6
.amdhsa_kernel k4_kernel
  .amdhsa_next_free_vgpr 256
  .amdhsa_next_free_sgpr 102
  .amdhsa_accum_offset 256
  .amdhsa_group_segment_fixed_size 0
  .amdhsa_kernarg_size 112
  .amdhsa_user_sgpr_count 2
  .amdhsa_user_sgpr_kernarg_segment_ptr 1
  .amdhsa_system_sgpr_workgroup_id_x 1
.end_amdhsa_kernel

.p2align 6
.amdhsa_kernel k5_kernel
  .amdhsa_next_free_vgpr 256
  .amdhsa_next_free_sgpr 102
  .amdhsa_accum_offset 256
  .amdhsa_group_segment_fixed_size 0
  .amdhsa_kernarg_size 112
  .amdhsa_user_sgpr_count 2
  .amdhsa_user_sgpr_kernarg_segment_ptr 1
  .amdhsa_system_sgpr_workgroup_id_x 1
.end_amdhsa_kernel

.p2align 6
.amdhsa_kernel k6_kernel
  .amdhsa_next_free_vgpr 256
  .amdhsa_next_free_sgpr 102
  .amdhsa_accum_offset 256
  .amdhsa_group_segment_fixed_size 0
  .amdhsa_kernarg_size 112
  .amdhsa_user_sgpr_count 2
  .amdhsa_user_sgpr_kernarg_segment_ptr 1
  .amdhsa_system_sgpr_workgroup_id_x 1
.end_amdhsa_kernel

.p2align 6
```
